```python
import torch

def _softmax(x, axis=-1):
    return torch.softmax(x, dim=axis)
def _gelu(x):
    return torch.nn.functional.gelu(x, approximate="tanh")
def _silu(x):
    return torch.nn.functional.silu(x)
def _sigmoid(x):
    return torch.sigmoid(x)
def _layernorm(x, axis=-1, eps=1e-5):
    m = x.mean(dim=axis, keepdim=True)
    v = x.var(dim=axis, keepdim=True, unbiased=False)
    return (x - m) / torch.sqrt(v + eps)
def _scatter_add(tgt, idx, src, axis=0):
    return tgt.clone().index_add_(axis, idx, src)
def _segment_sum(src, seg, n):
    out = torch.zeros((n,) + src.shape[1:], dtype=src.dtype)
    return out.index_add_(0, seg, src)
def _pad(x, pw):
    flat = tuple(v for pair in reversed(pw) for v in pair)
    return torch.nn.functional.pad(x, flat)

kernel_name = 'standalone__glu_gated_geglu__sampling'

def setup_inputs():

    _w = (lambda a: (lambda t: t.to(torch.bfloat16) if t.is_floating_point() else t)(torch.as_tensor(a)))
    B, S, Dm, Df = 8, 8, 1024, 3584
    return {
        "x": _w((lambda *s: torch.randn(*s, dtype=torch.bfloat16) * 0.05)(B, S, Dm)),
        "w_gate": _w((lambda *s: torch.randn(*s, dtype=torch.bfloat16) * 0.05)(Dm, Df) * (Dm ** -0.5)),
        "w_up": _w((lambda *s: torch.randn(*s, dtype=torch.bfloat16) * 0.05)(Dm, Df) * (Dm ** -0.5)),
        "w_down": _w((lambda *s: torch.randn(*s, dtype=torch.bfloat16) * 0.05)(Df, Dm) * (Df ** -0.5)),
    }

def reference(x, w_gate, w_up, w_down):
    g = torch.einsum("bsd,df->bsf", x, w_gate)
    u = torch.einsum("bsd,df->bsf", x, w_up)
    h = _gelu(g) * u
    return torch.einsum("bsf,fd->bsd", h, w_down)
```

```asm
; @launch grid=(256,1,1) block=(320,1,1) lds=163840
.amdgcn_target "amdgcn-amd-amdhsa--gfx950"
.text
.globl standalone__glu_gated_geglu__sampling_kernel
.p2align 8
.type standalone__glu_gated_geglu__sampling_kernel,@function
standalone__glu_gated_geglu__sampling_kernel:
    s_cmp_ge_u32 s2, 256
    s_cbranch_scc1 L_end
    s_load_dwordx2 s[24:25], s[0:1], 8
    s_load_dwordx2 s[28:29], s[0:1], 16
    s_load_dwordx2 s[20:21], s[0:1], 0
    s_load_dwordx2 s[32:33], s[0:1], 24
    s_load_dwordx2 s[44:45], s[0:1], 32
    s_load_dwordx2 s[12:13], s[0:1], 40
    s_load_dwordx2 s[36:37], s[0:1], 48
    v_lshrrev_b32 v1, 6, v0
    v_and_b32 v0, 63, v0
    s_and_b32 s18, s2, 7
    v_readfirstlane_b32 s3, v1
    s_lshr_b32 s19, s2, 3
    s_mov_b32 s26, 7340032
    s_mov_b32 s27, 0x00020000
    s_mov_b32 s30, 7340032
    s_mov_b32 s31, 0x00020000
    s_mov_b32 s22, 131072
    s_mov_b32 s23, 0x00020000
    s_mov_b32 s34, 7340032
    s_mov_b32 s35, 0x00020000
    s_mov_b32 s46, 131072
    s_mov_b32 s47, 0x00020000
    s_mov_b32 s38, 8388608
    s_mov_b32 s39, 0x00020000
    s_mov_b32 s14, 256
    s_mov_b32 s15, 0x00020000
    s_mul_i32 s53, s3, 20480
    s_cmp_eq_u32 s3, 4
    s_cbranch_scc1 L_service
    s_cmp_ge_u32 s19, 28
    s_cbranch_scc1 L_helper
    s_lshr_b32 s48, s19, 2
    s_mul_i32 s49, s18, 7
    s_add_u32 s48, s48, s49
    s_and_b32 s49, s19, 1
    s_lshl_b32 s49, s49, 1
    s_mul_i32 s50, s3, 1835008
    s_lshl_b32 s51, s48, 7
    s_add_u32 s50, s50, s51
    s_add_u32 s51, s50, 1835008
    s_mul_i32 s52, s49, 458752
    s_add_u32 s52, s52, s50
    v_lshrrev_b32 v2, 3, v0
    v_mul_u32_u24 v6, 7168, v2
    v_and_b32 v3, 7, v0
    v_bfe_u32 v4, v0, 4, 1
    v_lshlrev_b32 v4, 1, v4
    v_xor_b32 v3, v3, v4
    v_lshl_add_u32 v6, v3, 4, v6
    v_xor_b32 v7, 64, v6
    s_bitcmp1_b32 s19, 1
    s_waitcnt lgkmcnt(0)
    s_cselect_b32 s24, s28, s24
    s_cselect_b32 s25, s29, s25
    s_waitcnt lgkmcnt(0)
    s_add_u32 m0, s53, 0
    s_nop 0
    buffer_load_dwordx4 v6, s[24:27], s52 offen  lds
    s_add_u32 m0, s53, 1024
    s_add_u32 s56, s52, 57344
    buffer_load_dwordx4 v7, s[24:27], s56 offen  lds
    s_add_u32 m0, s53, 2048
    s_add_u32 s56, s52, 114688
    buffer_load_dwordx4 v6, s[24:27], s56 offen  lds
    s_add_u32 m0, s53, 3072
    s_add_u32 s56, s52, 172032
    buffer_load_dwordx4 v7, s[24:27], s56 offen  lds
    s_add_u32 s52, s52, 229376
    s_cmp_ge_u32 s52, s51
    s_cselect_b32 s52, s50, s52
    v_lshrrev_b32 v2, 3, v0
    v_lshlrev_b32 v8, 11, v2
    v_and_b32 v3, 7, v0
    v_bfe_u32 v4, v0, 4, 2
    v_xor_b32 v3, v3, v4
    v_lshl_add_u32 v8, v3, 4, v8
    v_xor_b32 v9, 64, v8
    v_add_u32 v9, 16384, v9
    s_and_b32 s54, s19, 1
    s_lshl_b32 s54, s54, 16
    s_lshl_b32 s55, s3, 9
    s_add_u32 s54, s54, s55
    s_lshl_b32 s55, s49, 7
    s_lshl_b32 s63, s3, 14
    s_add_u32 s63, s63, 81920
    s_and_b32 s57, s55, 511
    s_add_u32 s57, s57, s54
    s_add_u32 s55, s55, 128
    s_add_u32 m0, s63, 0
    s_nop 0
    buffer_load_dwordx4 v8, s[20:23], s57 offen lds
    s_add_u32 m0, s63, 1024
    s_nop 0
    buffer_load_dwordx4 v9, s[20:23], s57 offen lds
    s_add_u32 s57, s57, 32768
    s_add_u32 m0, s63, 8192
    s_nop 0
    buffer_load_dwordx4 v8, s[20:23], s57 offen lds
    s_add_u32 m0, s63, 9216
    s_nop 0
    buffer_load_dwordx4 v9, s[20:23], s57 offen lds
    s_and_b32 s57, s55, 511
    s_add_u32 s57, s57, s54
    s_add_u32 s55, s55, 128
    s_add_u32 m0, s63, 2048
    s_nop 0
    buffer_load_dwordx4 v8, s[20:23], s57 offen lds
    s_add_u32 m0, s63, 3072
    s_nop 0
    buffer_load_dwordx4 v9, s[20:23], s57 offen lds
    s_add_u32 s57, s57, 32768
    s_add_u32 m0, s63, 10240
    s_nop 0
    buffer_load_dwordx4 v8, s[20:23], s57 offen lds
    s_add_u32 m0, s63, 11264
    s_nop 0
    buffer_load_dwordx4 v9, s[20:23], s57 offen lds
    s_and_b32 s57, s55, 511
    s_add_u32 s57, s57, s54
    s_add_u32 s55, s55, 128
    s_add_u32 m0, s63, 4096
    s_nop 0
    buffer_load_dwordx4 v8, s[20:23], s57 offen lds
    s_add_u32 m0, s63, 5120
    s_nop 0
    buffer_load_dwordx4 v9, s[20:23], s57 offen lds
    s_add_u32 s57, s57, 32768
    s_add_u32 m0, s63, 12288
    s_nop 0
    buffer_load_dwordx4 v8, s[20:23], s57 offen lds
    s_add_u32 m0, s63, 13312
    s_nop 0
    buffer_load_dwordx4 v9, s[20:23], s57 offen lds
    s_and_b32 s57, s55, 511
    s_add_u32 s57, s57, s54
    s_add_u32 s55, s55, 128
    s_add_u32 m0, s63, 6144
    s_nop 0
    buffer_load_dwordx4 v8, s[20:23], s57 offen lds
    s_add_u32 m0, s63, 7168
    s_nop 0
    buffer_load_dwordx4 v9, s[20:23], s57 offen lds
    s_add_u32 s57, s57, 32768
    s_add_u32 m0, s63, 14336
    s_nop 0
    buffer_load_dwordx4 v8, s[20:23], s57 offen lds
    s_add_u32 m0, s63, 15360
    s_nop 0
    buffer_load_dwordx4 v9, s[20:23], s57 offen lds
    s_add_u32 m0, s53, 4096
    s_nop 0
    buffer_load_dwordx4 v6, s[24:27], s52 offen  lds
    s_add_u32 m0, s53, 5120
    s_add_u32 s56, s52, 57344
    buffer_load_dwordx4 v7, s[24:27], s56 offen  lds
    s_add_u32 m0, s53, 6144
    s_add_u32 s56, s52, 114688
    buffer_load_dwordx4 v6, s[24:27], s56 offen  lds
    s_add_u32 m0, s53, 7168
    s_add_u32 s56, s52, 172032
    buffer_load_dwordx4 v7, s[24:27], s56 offen  lds
    s_add_u32 s52, s52, 229376
    s_cmp_ge_u32 s52, s51
    s_cselect_b32 s52, s50, s52
    s_add_u32 m0, s53, 8192
    s_nop 0
    buffer_load_dwordx4 v6, s[24:27], s52 offen  lds
    s_add_u32 m0, s53, 9216
    s_add_u32 s56, s52, 57344
    buffer_load_dwordx4 v7, s[24:27], s56 offen  lds
    s_add_u32 m0, s53, 10240
    s_add_u32 s56, s52, 114688
    buffer_load_dwordx4 v6, s[24:27], s56 offen  lds
    s_add_u32 m0, s53, 11264
    s_add_u32 s56, s52, 172032
    buffer_load_dwordx4 v7, s[24:27], s56 offen  lds
    s_add_u32 s52, s52, 229376
    s_cmp_ge_u32 s52, s51
    s_cselect_b32 s52, s50, s52
    s_add_u32 m0, s53, 12288
    s_nop 0
    buffer_load_dwordx4 v6, s[24:27], s52 offen  lds
    s_add_u32 m0, s53, 13312
    s_add_u32 s56, s52, 57344
    buffer_load_dwordx4 v7, s[24:27], s56 offen  lds
    s_add_u32 m0, s53, 14336
    s_add_u32 s56, s52, 114688
    buffer_load_dwordx4 v6, s[24:27], s56 offen  lds
    s_add_u32 m0, s53, 15360
    s_add_u32 s56, s52, 172032
    buffer_load_dwordx4 v7, s[24:27], s56 offen  lds
    s_add_u32 s52, s52, 229376
    s_cmp_ge_u32 s52, s51
    s_cselect_b32 s52, s50, s52
    s_add_u32 m0, s53, 16384
    s_nop 0
    buffer_load_dwordx4 v6, s[24:27], s52 offen  lds
    s_add_u32 m0, s53, 17408
    s_add_u32 s56, s52, 57344
    buffer_load_dwordx4 v7, s[24:27], s56 offen  lds
    s_add_u32 m0, s53, 18432
    s_add_u32 s56, s52, 114688
    buffer_load_dwordx4 v6, s[24:27], s56 offen  lds
    s_add_u32 m0, s53, 19456
    s_add_u32 s56, s52, 172032
    buffer_load_dwordx4 v7, s[24:27], s56 offen  lds
    s_add_u32 s52, s52, 229376
    s_cmp_ge_u32 s52, s51
    s_cselect_b32 s52, s50, s52
    v_lshrrev_b32 v2, 4, v0
    v_bfe_u32 v3, v0, 2, 2
    v_lshlrev_b32 v4, 3, v2
    v_add_u32 v4, v4, v3
    v_lshlrev_b32 v4, 7, v4
    v_and_b32 v5, 3, v0
    v_lshl_add_u32 v4, v5, 3, v4
    v_bfe_u32 v5, v0, 3, 2
    v_lshlrev_b32 v5, 5, v5
    v_add_u32 v4, s53, v4
    v_add_u32 v10, v4, v5
    v_xor_b32 v3, 32, v5
    v_add_u32 v11, v4, v3
    v_xor_b32 v3, 64, v5
    v_add_u32 v12, v4, v3
    v_xor_b32 v3, 96, v5
    v_add_u32 v13, v4, v3
    v_and_b32 v2, 15, v0
    v_lshlrev_b32 v8, 7, v2
    v_lshrrev_b32 v3, 4, v0
    v_lshrrev_b32 v4, 1, v2
    v_xor_b32 v3, v3, v4
    v_lshl_add_u32 v8, v3, 4, v8
    v_add_u32 v8, s63, v8
    v_xor_b32 v9, 64, v8
    s_mov_b32 s96, 131072
    s_mov_b32 s97, 1048576
    s_lshr_b32 s82, s19, 1
    s_and_b32 s83, s19, 1
    s_and_b32 s84, s3, 1
    s_lshr_b32 s85, s3, 1
    v_lshlrev_b32 v225, 4, v0
    s_mul_i32 s86, s84, 28672
    s_add_u32 s86, s86, 81920
    s_lshl_b32 s87, s84, 6
    v_lshrrev_b32 v2, 4, v0
    v_bfe_u32 v3, v0, 2, 2
    v_lshlrev_b32 v4, 2, v2
    v_add_u32 v4, v4, v3
    v_lshlrev_b32 v4, 7, v4
    v_and_b32 v5, 3, v0
    v_lshl_add_u32 v4, v5, 3, v4
    v_bfe_u32 v5, v0, 3, 2
    v_lshlrev_b32 v5, 5, v5
    v_xor_b32 v5, s87, v5
    v_add_u32 v4, s86, v4
    v_add_u32 v226, v4, v5
    v_xor_b32 v3, 32, v5
    v_add_u32 v227, v4, v3
    v_xor_b32 v3, 64, v5
    v_add_u32 v228, v4, v3
    v_xor_b32 v3, 96, v5
    v_add_u32 v229, v4, v3
    s_lshl_b32 s86, s83, 1
    s_add_u32 s86, s86, s85
    s_mul_i32 s86, s86, 112
    s_mul_i32 s87, s18, 14
    s_add_u32 s86, s86, s87
    s_mul_i32 s87, s84, 7
    s_add_u32 s86, s86, s87
    s_lshl_b32 s88, s86, 11
    s_add_u32 s88, s88, 0
    s_add_u32 s89, s88, 4096
    s_add_u32 s6, s88, 8192
    s_add_u32 s7, s88, 12288
    s_mov_b32 s98, 0xffff0000
    s_add_u32 s86, s53, 8192
    v_add_u32 v236, s86, v225
    s_xor_b32 s86, s3, 1
    s_mul_i32 s86, s86, 20480
    s_add_u32 s86, s86, 8192
    v_add_u32 v237, s86, v225
    s_lshl_b32 s81, s83, 4
    s_add_u32 s81, s81, s82
    s_lshl_b32 s86, s81, 3
    s_lshl_b32 s87, s3, 1
    s_add_u32 s86, s86, s87
    s_lshl_b32 s86, s86, 3
    s_add_u32 s86, s86, s18
    s_lshl_b32 s90, s86, 11
    s_add_u32 s90, s90, 1048576
    s_add_u32 s91, s90, 16384
    v_add_u32 v2, 640, v225
    v_lshrrev_b32 v2, 10, v2
    v_lshl_add_u32 v234, v2, 7, v225
    s_lshl_b32 s92, s81, 3
    s_add_u32 s92, s92, s18
    s_lshl_b32 s92, s92, 14
    s_add_u32 s92, s92, 1048576
    s_add_u32 s93, s92, 4096
    s_add_u32 s4, s92, 8192
    s_add_u32 s5, s92, 12288
    s_lshl_b32 s94, s83, 1
    s_lshr_b32 s95, s18, 2
    s_add_u32 s94, s94, s95
    s_lshl_b32 s94, s94, 15
    s_lshl_b32 s95, s82, 7
    s_add_u32 s94, s94, s95
    s_and_b32 s95, s18, 3
    s_lshl_b32 s95, s95, 5
    s_add_u32 s94, s94, s95
    v_and_b32 v2, 15, v0
    v_lshlrev_b32 v238, 11, v2
    v_lshrrev_b32 v2, 4, v0
    v_lshl_add_u32 v238, v2, 3, v238
    v_mov_b32 v239, 147456
    s_lshl_b32 s95, s3, 2
    v_add_u32 v15, s95, v239
    v_xor_b32 v224, 20, v15
    v_mov_b32 v14, 1
    v_add_u32 v230, s53, v225
    v_and_b32 v3, 31, v0
    v_lshrrev_b32 v4, 5, v0
    s_lshl_b32 s58, s84, 9
    s_lshl_b32 s59, s85, 11
    s_add_u32 s58, s58, s59
    v_lshlrev_b32 v5, 4, v3
    v_lshl_add_u32 v231, v4, 10, v5
    v_add_u32 v231, s58, v231
    v_add_u32 v232, 40960, v231
    v_lshl_add_u32 v233, v4, 30, v5
    s_mul_i32 s62, s83, 224
    s_lshl_b32 s61, s48, 1
    s_add_u32 s62, s62, s61
    s_add_u32 s62, s62, s85
    s_lshl_b32 s62, s62, 1
    s_bfe_u32 s61, s19, 0x10001
    s_add_u32 s62, s62, s61
    v_mul_u32_u24 v4, 229376, v4
    v_add_u32 v233, v4, v5
    s_lshl_b32 s62, s62, 10
    s_lshl_b32 s61, s84, 9
    s_add_u32 s62, s62, s61
    s_add_u32 s62, s62, 0
    v_mov_b32 v244, 0xc0135761
    v_mov_b32 v245, 0xc0135761
    v_mov_b32 v246, 0xbdd2d3e8
    v_mov_b32 v247, 0xbdd2d3e8
    s_mov_b32 s98, 0xffff0000
    v_mov_b32 v242, 0
    v_mov_b32 v243, 0
    s_waitcnt vmcnt(32)
    ds_read_b64_tr_b16 v[80:81], v10 offset:0
    ds_read_b64_tr_b16 v[82:83], v10 offset:512
    ds_read_b64_tr_b16 v[84:85], v11 offset:0
    ds_read_b64_tr_b16 v[86:87], v11 offset:512
    ds_read_b64_tr_b16 v[88:89], v12 offset:0
    ds_read_b64_tr_b16 v[90:91], v12 offset:512
    ds_read_b64_tr_b16 v[92:93], v13 offset:0
    ds_read_b64_tr_b16 v[94:95], v13 offset:512
    s_waitcnt lgkmcnt(0)
    s_add_u32 m0, s53, 0
    s_nop 0
    buffer_load_dwordx4 v6, s[24:27], s52 offen  lds
    s_add_u32 m0, s53, 1024
    s_add_u32 s56, s52, 57344
    buffer_load_dwordx4 v7, s[24:27], s56 offen  lds
    s_add_u32 m0, s53, 2048
    s_add_u32 s56, s52, 114688
    buffer_load_dwordx4 v6, s[24:27], s56 offen  lds
    s_add_u32 m0, s53, 3072
    s_add_u32 s56, s52, 172032
    buffer_load_dwordx4 v7, s[24:27], s56 offen  lds
    s_add_u32 s52, s52, 229376
    s_cmp_ge_u32 s52, s51
    s_cselect_b32 s52, s50, s52
    s_waitcnt vmcnt(20)
    ds_read_b128 v[16:19], v8 offset:0
    ds_read_b128 v[20:23], v9 offset:0
    ds_read_b128 v[24:27], v8 offset:2048
    ds_read_b128 v[28:31], v9 offset:2048
    ds_read_b128 v[32:35], v8 offset:4096
    ds_read_b128 v[36:39], v9 offset:4096
    ds_read_b128 v[40:43], v8 offset:6144
    ds_read_b128 v[44:47], v9 offset:6144
    ds_read_b128 v[48:51], v8 offset:8192
    ds_read_b128 v[52:55], v9 offset:8192
    ds_read_b128 v[56:59], v8 offset:10240
    ds_read_b128 v[60:63], v9 offset:10240
    ds_read_b128 v[64:67], v8 offset:12288
    ds_read_b128 v[68:71], v9 offset:12288
    ds_read_b128 v[72:75], v8 offset:14336
    ds_read_b128 v[76:79], v9 offset:14336
    s_waitcnt lgkmcnt(0)
    v_mfma_f32_16x16x32_bf16 v[96:99], v[80:83], v[16:19], 0
    v_mfma_f32_16x16x32_bf16 v[100:103], v[84:87], v[16:19], 0
    v_mfma_f32_16x16x32_bf16 v[104:107], v[88:91], v[16:19], 0
    v_mfma_f32_16x16x32_bf16 v[108:111], v[92:95], v[16:19], 0
    v_mfma_f32_16x16x32_bf16 v[112:115], v[80:83], v[48:51], 0
    v_mfma_f32_16x16x32_bf16 v[116:119], v[84:87], v[48:51], 0
    v_mfma_f32_16x16x32_bf16 v[120:123], v[88:91], v[48:51], 0
    v_mfma_f32_16x16x32_bf16 v[124:127], v[92:95], v[48:51], 0
    s_waitcnt vmcnt(16)
    ds_read_b64_tr_b16 v[80:81], v10 offset:4096
    ds_read_b64_tr_b16 v[82:83], v10 offset:4608
    ds_read_b64_tr_b16 v[84:85], v11 offset:4096
    ds_read_b64_tr_b16 v[86:87], v11 offset:4608
    ds_read_b64_tr_b16 v[88:89], v12 offset:4096
    ds_read_b64_tr_b16 v[90:91], v12 offset:4608
    ds_read_b64_tr_b16 v[92:93], v13 offset:4096
    ds_read_b64_tr_b16 v[94:95], v13 offset:4608
    s_waitcnt lgkmcnt(0)
    s_add_u32 m0, s53, 4096
    s_nop 0
    buffer_load_dwordx4 v6, s[24:27], s52 offen  lds
    s_add_u32 m0, s53, 5120
    s_add_u32 s56, s52, 57344
    buffer_load_dwordx4 v7, s[24:27], s56 offen  lds
    s_add_u32 m0, s53, 6144
    s_add_u32 s56, s52, 114688
    buffer_load_dwordx4 v6, s[24:27], s56 offen  lds
    s_add_u32 m0, s53, 7168
    s_add_u32 s56, s52, 172032
    buffer_load_dwordx4 v7, s[24:27], s56 offen  lds
    s_add_u32 s52, s52, 229376
    s_cmp_ge_u32 s52, s51
    s_cselect_b32 s52, s50, s52
    s_barrier
    v_mfma_f32_16x16x32_bf16 v[96:99], v[80:83], v[20:23], v[96:99]
    v_mfma_f32_16x16x32_bf16 v[100:103], v[84:87], v[20:23], v[100:103]
    v_mfma_f32_16x16x32_bf16 v[104:107], v[88:91], v[20:23], v[104:107]
    v_mfma_f32_16x16x32_bf16 v[108:111], v[92:95], v[20:23], v[108:111]
    v_mfma_f32_16x16x32_bf16 v[112:115], v[80:83], v[52:55], v[112:115]
    v_mfma_f32_16x16x32_bf16 v[116:119], v[84:87], v[52:55], v[116:119]
    v_mfma_f32_16x16x32_bf16 v[120:123], v[88:91], v[52:55], v[120:123]
    v_mfma_f32_16x16x32_bf16 v[124:127], v[92:95], v[52:55], v[124:127]
    s_waitcnt vmcnt(16)
    ds_read_b64_tr_b16 v[80:81], v10 offset:8192
    ds_read_b64_tr_b16 v[82:83], v10 offset:8704
    ds_read_b64_tr_b16 v[84:85], v11 offset:8192
    ds_read_b64_tr_b16 v[86:87], v11 offset:8704
    ds_read_b64_tr_b16 v[88:89], v12 offset:8192
    ds_read_b64_tr_b16 v[90:91], v12 offset:8704
    ds_read_b64_tr_b16 v[92:93], v13 offset:8192
    ds_read_b64_tr_b16 v[94:95], v13 offset:8704
    s_waitcnt lgkmcnt(0)
    s_add_u32 m0, s53, 8192
    s_nop 0
    buffer_load_dwordx4 v6, s[24:27], s52 offen  lds
    s_add_u32 m0, s53, 9216
    s_add_u32 s56, s52, 57344
    buffer_load_dwordx4 v7, s[24:27], s56 offen  lds
    s_add_u32 m0, s53, 10240
    s_add_u32 s56, s52, 114688
    buffer_load_dwordx4 v6, s[24:27], s56 offen  lds
    s_add_u32 m0, s53, 11264
    s_add_u32 s56, s52, 172032
    buffer_load_dwordx4 v7, s[24:27], s56 offen  lds
    v_mfma_f32_16x16x32_bf16 v[96:99], v[80:83], v[24:27], v[96:99]
    v_mfma_f32_16x16x32_bf16 v[100:103], v[84:87], v[24:27], v[100:103]
    v_mfma_f32_16x16x32_bf16 v[104:107], v[88:91], v[24:27], v[104:107]
    v_mfma_f32_16x16x32_bf16 v[108:111], v[92:95], v[24:27], v[108:111]
    v_mfma_f32_16x16x32_bf16 v[112:115], v[80:83], v[56:59], v[112:115]
    v_mfma_f32_16x16x32_bf16 v[116:119], v[84:87], v[56:59], v[116:119]
    v_mfma_f32_16x16x32_bf16 v[120:123], v[88:91], v[56:59], v[120:123]
    v_mfma_f32_16x16x32_bf16 v[124:127], v[92:95], v[56:59], v[124:127]
    s_waitcnt vmcnt(16)
    ds_read_b64_tr_b16 v[80:81], v10 offset:12288
    ds_read_b64_tr_b16 v[82:83], v10 offset:12800
    ds_read_b64_tr_b16 v[84:85], v11 offset:12288
    ds_read_b64_tr_b16 v[86:87], v11 offset:12800
    ds_read_b64_tr_b16 v[88:89], v12 offset:12288
    ds_read_b64_tr_b16 v[90:91], v12 offset:12800
    ds_read_b64_tr_b16 v[92:93], v13 offset:12288
    ds_read_b64_tr_b16 v[94:95], v13 offset:12800
    s_waitcnt lgkmcnt(0)
    v_mfma_f32_16x16x32_bf16 v[96:99], v[80:83], v[28:31], v[96:99]
    v_mfma_f32_16x16x32_bf16 v[100:103], v[84:87], v[28:31], v[100:103]
    v_mfma_f32_16x16x32_bf16 v[104:107], v[88:91], v[28:31], v[104:107]
    v_mfma_f32_16x16x32_bf16 v[108:111], v[92:95], v[28:31], v[108:111]
    v_mfma_f32_16x16x32_bf16 v[112:115], v[80:83], v[60:63], v[112:115]
    v_mfma_f32_16x16x32_bf16 v[116:119], v[84:87], v[60:63], v[116:119]
    v_mfma_f32_16x16x32_bf16 v[120:123], v[88:91], v[60:63], v[120:123]
    v_mfma_f32_16x16x32_bf16 v[124:127], v[92:95], v[60:63], v[124:127]
    s_waitcnt vmcnt(12)
    ds_read_b64_tr_b16 v[80:81], v10 offset:16384
    ds_read_b64_tr_b16 v[82:83], v10 offset:16896
    ds_read_b64_tr_b16 v[84:85], v11 offset:16384
    ds_read_b64_tr_b16 v[86:87], v11 offset:16896
    ds_read_b64_tr_b16 v[88:89], v12 offset:16384
    ds_read_b64_tr_b16 v[90:91], v12 offset:16896
    ds_read_b64_tr_b16 v[92:93], v13 offset:16384
    ds_read_b64_tr_b16 v[94:95], v13 offset:16896
    s_waitcnt lgkmcnt(0)
    s_barrier
    v_mfma_f32_16x16x32_bf16 v[96:99], v[80:83], v[32:35], v[96:99]
    v_mfma_f32_16x16x32_bf16 v[100:103], v[84:87], v[32:35], v[100:103]
    v_mfma_f32_16x16x32_bf16 v[104:107], v[88:91], v[32:35], v[104:107]
    v_mfma_f32_16x16x32_bf16 v[108:111], v[92:95], v[32:35], v[108:111]
    v_mfma_f32_16x16x32_bf16 v[112:115], v[80:83], v[64:67], v[112:115]
    v_mfma_f32_16x16x32_bf16 v[116:119], v[84:87], v[64:67], v[116:119]
    v_mfma_f32_16x16x32_bf16 v[120:123], v[88:91], v[64:67], v[120:123]
    v_mfma_f32_16x16x32_bf16 v[124:127], v[92:95], v[64:67], v[124:127]
    s_waitcnt vmcnt(8)
    ds_read_b64_tr_b16 v[80:81], v10 offset:0
    ds_read_b64_tr_b16 v[82:83], v10 offset:512
    ds_read_b64_tr_b16 v[84:85], v11 offset:0
    ds_read_b64_tr_b16 v[86:87], v11 offset:512
    ds_read_b64_tr_b16 v[88:89], v12 offset:0
    ds_read_b64_tr_b16 v[90:91], v12 offset:512
    ds_read_b64_tr_b16 v[92:93], v13 offset:0
    ds_read_b64_tr_b16 v[94:95], v13 offset:512
    s_waitcnt lgkmcnt(0)
    v_mfma_f32_16x16x32_bf16 v[96:99], v[80:83], v[36:39], v[96:99]
    v_mfma_f32_16x16x32_bf16 v[100:103], v[84:87], v[36:39], v[100:103]
    v_mfma_f32_16x16x32_bf16 v[104:107], v[88:91], v[36:39], v[104:107]
    v_mfma_f32_16x16x32_bf16 v[108:111], v[92:95], v[36:39], v[108:111]
    v_mfma_f32_16x16x32_bf16 v[112:115], v[80:83], v[68:71], v[112:115]
    v_mfma_f32_16x16x32_bf16 v[116:119], v[84:87], v[68:71], v[116:119]
    v_mfma_f32_16x16x32_bf16 v[120:123], v[88:91], v[68:71], v[120:123]
    v_mfma_f32_16x16x32_bf16 v[124:127], v[92:95], v[68:71], v[124:127]
    s_waitcnt vmcnt(4)
    ds_read_b64_tr_b16 v[80:81], v10 offset:4096
    ds_read_b64_tr_b16 v[82:83], v10 offset:4608
    ds_read_b64_tr_b16 v[84:85], v11 offset:4096
    ds_read_b64_tr_b16 v[86:87], v11 offset:4608
    ds_read_b64_tr_b16 v[88:89], v12 offset:4096
    ds_read_b64_tr_b16 v[90:91], v12 offset:4608
    ds_read_b64_tr_b16 v[92:93], v13 offset:4096
    ds_read_b64_tr_b16 v[94:95], v13 offset:4608
    s_waitcnt lgkmcnt(0)
    v_mfma_f32_16x16x32_bf16 v[96:99], v[80:83], v[40:43], v[96:99]
    v_mfma_f32_16x16x32_bf16 v[100:103], v[84:87], v[40:43], v[100:103]
    v_mfma_f32_16x16x32_bf16 v[104:107], v[88:91], v[40:43], v[104:107]
    v_mfma_f32_16x16x32_bf16 v[108:111], v[92:95], v[40:43], v[108:111]
    v_mfma_f32_16x16x32_bf16 v[112:115], v[80:83], v[72:75], v[112:115]
    v_mfma_f32_16x16x32_bf16 v[116:119], v[84:87], v[72:75], v[116:119]
    v_mfma_f32_16x16x32_bf16 v[120:123], v[88:91], v[72:75], v[120:123]
    v_mfma_f32_16x16x32_bf16 v[124:127], v[92:95], v[72:75], v[124:127]
    s_waitcnt vmcnt(0)
    ds_read_b64_tr_b16 v[80:81], v10 offset:8192
    ds_read_b64_tr_b16 v[82:83], v10 offset:8704
    ds_read_b64_tr_b16 v[84:85], v11 offset:8192
    ds_read_b64_tr_b16 v[86:87], v11 offset:8704
    ds_read_b64_tr_b16 v[88:89], v12 offset:8192
    ds_read_b64_tr_b16 v[90:91], v12 offset:8704
    ds_read_b64_tr_b16 v[92:93], v13 offset:8192
    ds_read_b64_tr_b16 v[94:95], v13 offset:8704
    s_waitcnt lgkmcnt(0)
    v_mfma_f32_16x16x32_bf16 v[96:99], v[80:83], v[44:47], v[96:99]
    v_mfma_f32_16x16x32_bf16 v[100:103], v[84:87], v[44:47], v[100:103]
    v_mfma_f32_16x16x32_bf16 v[104:107], v[88:91], v[44:47], v[104:107]
    v_mfma_f32_16x16x32_bf16 v[108:111], v[92:95], v[44:47], v[108:111]
    v_mfma_f32_16x16x32_bf16 v[112:115], v[80:83], v[76:79], v[112:115]
    v_mfma_f32_16x16x32_bf16 v[116:119], v[84:87], v[76:79], v[116:119]
    v_mfma_f32_16x16x32_bf16 v[120:123], v[88:91], v[76:79], v[120:123]
    v_mfma_f32_16x16x32_bf16 v[124:127], v[92:95], v[76:79], v[124:127]
    s_nop 0
    ds_write_b128 v230, v[96:99] offset:0
    ds_write_b128 v230, v[100:103] offset:1024
    ds_write_b128 v230, v[104:107] offset:2048
    ds_write_b128 v230, v[108:111] offset:3072
    ds_write_b128 v230, v[112:115] offset:4096
    ds_write_b128 v230, v[116:119] offset:5120
    ds_write_b128 v230, v[120:123] offset:6144
    ds_write_b128 v230, v[124:127] offset:7168
    ds_write_b32 v15, v14
    ds_read_b128 v[48:51], v239
    ds_read_b128 v[16:19], v231 offset:0
    ds_read_b128 v[32:35], v231 offset:4096
    ds_read_b128 v[20:23], v231 offset:20480
    ds_read_b128 v[36:39], v231 offset:24576
    ds_read_b128 v[24:27], v232 offset:0
    ds_read_b128 v[40:43], v232 offset:4096
    ds_read_b128 v[28:31], v232 offset:20480
    ds_read_b128 v[44:47], v232 offset:24576
    s_waitcnt lgkmcnt(8)
    v_min3_u32 v1, v48, v49, v50
    v_min_u32 v1, v1, v51
    v_cmp_eq_u32 vcc, 0, v1
    s_cbranch_vccnz L_lre
L_lok:
    s_waitcnt lgkmcnt(0)
    v_pk_add_f32 v[16:17], v[16:17], v[20:21]
    v_pk_add_f32 v[18:19], v[18:19], v[22:23]
    v_pk_add_f32 v[24:25], v[24:25], v[28:29]
    v_pk_add_f32 v[26:27], v[26:27], v[30:31]
    v_pk_add_f32 v[32:33], v[32:33], v[36:37]
    v_pk_add_f32 v[34:35], v[34:35], v[38:39]
    v_pk_add_f32 v[40:41], v[40:41], v[44:45]
    v_pk_add_f32 v[42:43], v[42:43], v[46:47]
    v_pk_add_f32 v[16:17], v[16:17], v[24:25]
    v_pk_add_f32 v[18:19], v[18:19], v[26:27]
    v_pk_add_f32 v[32:33], v[32:33], v[40:41]
    v_pk_add_f32 v[34:35], v[34:35], v[42:43]
    s_bitcmp1_b32 s19, 1
    s_cbranch_scc1 L_ufin
    buffer_load_dwordx4 v[52:55], v233, s[36:39], s62 offen offset:1024 sc1
    v_cvt_pk_bf16_f32 v48, v16, v17
    v_cvt_pk_bf16_f32 v49, v18, v19
    v_cvt_pk_bf16_f32 v50, v32, v33
    v_cvt_pk_bf16_f32 v51, v34, v35
    v_lshlrev_b32 v16, 16, v48
    v_and_b32 v17, s98, v48
    v_lshlrev_b32 v18, 16, v49
    v_and_b32 v19, s98, v49
    v_lshlrev_b32 v20, 16, v50
    v_and_b32 v21, s98, v50
    v_lshlrev_b32 v22, 16, v51
    v_and_b32 v23, s98, v51
    v_pk_mul_f32 v[24:25], v[16:17], v[16:17]
    v_pk_mul_f32 v[26:27], v[18:19], v[18:19]
    v_pk_mul_f32 v[28:29], v[20:21], v[20:21]
    v_pk_mul_f32 v[30:31], v[22:23], v[22:23]
    v_pk_fma_f32 v[24:25], v[24:25], v[246:247], v[244:245]
    v_pk_fma_f32 v[26:27], v[26:27], v[246:247], v[244:245]
    v_pk_fma_f32 v[28:29], v[28:29], v[246:247], v[244:245]
    v_pk_fma_f32 v[30:31], v[30:31], v[246:247], v[244:245]
    v_pk_mul_f32 v[24:25], v[24:25], v[16:17]
    v_pk_mul_f32 v[26:27], v[26:27], v[18:19]
    v_pk_mul_f32 v[28:29], v[28:29], v[20:21]
    v_pk_mul_f32 v[30:31], v[30:31], v[22:23]
    v_exp_f32 v24, v24
    v_exp_f32 v25, v25
    v_exp_f32 v26, v26
    v_exp_f32 v27, v27
    v_exp_f32 v28, v28
    v_exp_f32 v29, v29
    v_exp_f32 v30, v30
    v_exp_f32 v31, v31
    v_add_f32 v24, 1.0, v24
    v_add_f32 v25, 1.0, v25
    v_add_f32 v26, 1.0, v26
    v_add_f32 v27, 1.0, v27
    v_add_f32 v28, 1.0, v28
    v_add_f32 v29, 1.0, v29
    v_add_f32 v30, 1.0, v30
    v_add_f32 v31, 1.0, v31
    v_rcp_f32 v24, v24
    v_rcp_f32 v25, v25
    v_rcp_f32 v26, v26
    v_rcp_f32 v27, v27
    v_rcp_f32 v28, v28
    v_rcp_f32 v29, v29
    v_rcp_f32 v30, v30
    v_rcp_f32 v31, v31
    v_pk_mul_f32 v[16:17], v[16:17], v[24:25]
    v_pk_mul_f32 v[18:19], v[18:19], v[26:27]
    v_pk_mul_f32 v[20:21], v[20:21], v[28:29]
    v_pk_mul_f32 v[22:23], v[22:23], v[30:31]
    v_cvt_pk_bf16_f32 v240, v16, v17
    v_cvt_pk_bf16_f32 v241, v18, v19
    v_cvt_pk_bf16_f32 v242, v20, v21
    v_cvt_pk_bf16_f32 v243, v22, v23
    s_nop 0
    v_permlane32_swap_b32 v240, v242
    v_permlane32_swap_b32 v241, v243
L_uchk:
    s_waitcnt vmcnt(0)
    v_max3_u32 v1, v52, v53, v54
    v_max_u32 v1, v1, v55
    v_cmp_eq_u32 vcc, -1, v1
    s_cbranch_vccnz L_ure
L_uok:
    v_and_b32 v56, s98, v52
    v_and_b32 v52, 0xffff, v52
    v_and_b32 v57, s98, v53
    v_and_b32 v53, 0xffff, v53
    v_and_b32 v58, s98, v54
    v_and_b32 v54, 0xffff, v54
    v_and_b32 v59, s98, v55
    v_and_b32 v55, 0xffff, v55
    v_dot2_f32_bf16 v16, v240, v52, 0
    v_dot2_f32_bf16 v17, v240, v56, 0
    v_dot2_f32_bf16 v18, v241, v53, 0
    v_dot2_f32_bf16 v19, v241, v57, 0
    v_dot2_f32_bf16 v20, v242, v54, 0
    v_dot2_f32_bf16 v21, v242, v58, 0
    v_dot2_f32_bf16 v22, v243, v55, 0
    v_dot2_f32_bf16 v23, v243, v59, 0
    v_cvt_pk_bf16_f32 v240, v16, v17
    v_cvt_pk_bf16_f32 v241, v18, v19
    v_cvt_pk_bf16_f32 v242, v20, v21
    v_cvt_pk_bf16_f32 v243, v22, v23
L_ucom:
    v_min_u32 v240, -2, v240
    v_min_u32 v241, -2, v241
    v_min_u32 v242, -2, v242
    v_min_u32 v243, -2, v243
    buffer_store_dwordx4 v[240:243], v233, s[36:39], s62 offen
L_p2:
    buffer_load_dwordx4 v[16:19], v225, s[36:39], s88 offen offset:0 sc1
    buffer_load_dwordx4 v[20:23], v225, s[36:39], s88 offen offset:2048 sc1
    buffer_load_dwordx4 v[24:27], v225, s[36:39], s89 offen offset:0 sc1
    buffer_load_dwordx4 v[28:31], v225, s[36:39], s89 offen offset:2048 sc1
    buffer_load_dwordx4 v[32:35], v225, s[36:39], s6 offen offset:0 sc1
    buffer_load_dwordx4 v[36:39], v225, s[36:39], s6 offen offset:2048 sc1
    buffer_load_dwordx4 v[40:43], v225, s[36:39], s7 offen offset:0 sc1
    s_mov_b32 s99, 0
    s_cmp_eq_u32 s83, s83
    s_cbranch_scc1 L_erd
L_ebar:
    s_barrier
    s_mov_b32 s99, 1
L_erd:
    ds_read_b32 v1, v239 offset:32
    ds_read_b64_tr_b16 v[112:113], v226 offset:0
    ds_read_b64_tr_b16 v[114:115], v226 offset:2048
    ds_read_b64_tr_b16 v[116:117], v227 offset:0
    ds_read_b64_tr_b16 v[118:119], v227 offset:2048
    ds_read_b64_tr_b16 v[120:121], v228 offset:0
    ds_read_b64_tr_b16 v[122:123], v228 offset:2048
    ds_read_b64_tr_b16 v[124:125], v229 offset:0
    ds_read_b64_tr_b16 v[126:127], v229 offset:2048
    ds_read_b64_tr_b16 v[128:129], v226 offset:4096
    ds_read_b64_tr_b16 v[130:131], v226 offset:6144
    ds_read_b64_tr_b16 v[132:133], v227 offset:4096
    ds_read_b64_tr_b16 v[134:135], v227 offset:6144
    ds_read_b64_tr_b16 v[136:137], v228 offset:4096
    ds_read_b64_tr_b16 v[138:139], v228 offset:6144
    ds_read_b64_tr_b16 v[140:141], v229 offset:4096
    ds_read_b64_tr_b16 v[142:143], v229 offset:6144
    ds_read_b64_tr_b16 v[144:145], v226 offset:8192
    ds_read_b64_tr_b16 v[146:147], v226 offset:10240
    ds_read_b64_tr_b16 v[148:149], v227 offset:8192
    ds_read_b64_tr_b16 v[150:151], v227 offset:10240
    ds_read_b64_tr_b16 v[152:153], v228 offset:8192
    ds_read_b64_tr_b16 v[154:155], v228 offset:10240
    ds_read_b64_tr_b16 v[156:157], v229 offset:8192
    ds_read_b64_tr_b16 v[158:159], v229 offset:10240
    ds_read_b64_tr_b16 v[160:161], v226 offset:12288
    ds_read_b64_tr_b16 v[162:163], v226 offset:14336
    ds_read_b64_tr_b16 v[164:165], v227 offset:12288
    ds_read_b64_tr_b16 v[166:167], v227 offset:14336
    ds_read_b64_tr_b16 v[168:169], v228 offset:12288
    ds_read_b64_tr_b16 v[170:171], v228 offset:14336
    ds_read_b64_tr_b16 v[172:173], v229 offset:12288
    ds_read_b64_tr_b16 v[174:175], v229 offset:14336
    ds_read_b64_tr_b16 v[176:177], v226 offset:16384
    ds_read_b64_tr_b16 v[178:179], v226 offset:18432
    ds_read_b64_tr_b16 v[180:181], v227 offset:16384
    ds_read_b64_tr_b16 v[182:183], v227 offset:18432
    ds_read_b64_tr_b16 v[184:185], v228 offset:16384
    ds_read_b64_tr_b16 v[186:187], v228 offset:18432
    ds_read_b64_tr_b16 v[188:189], v229 offset:16384
    ds_read_b64_tr_b16 v[190:191], v229 offset:18432
    ds_read_b64_tr_b16 v[192:193], v226 offset:20480
    ds_read_b64_tr_b16 v[194:195], v226 offset:22528
    ds_read_b64_tr_b16 v[196:197], v227 offset:20480
    ds_read_b64_tr_b16 v[198:199], v227 offset:22528
    ds_read_b64_tr_b16 v[200:201], v228 offset:20480
    ds_read_b64_tr_b16 v[202:203], v228 offset:22528
    ds_read_b64_tr_b16 v[204:205], v229 offset:20480
    ds_read_b64_tr_b16 v[206:207], v229 offset:22528
    ds_read_b64_tr_b16 v[208:209], v226 offset:24576
    ds_read_b64_tr_b16 v[210:211], v226 offset:26624
    ds_read_b64_tr_b16 v[212:213], v227 offset:24576
    ds_read_b64_tr_b16 v[214:215], v227 offset:26624
    ds_read_b64_tr_b16 v[216:217], v228 offset:24576
    ds_read_b64_tr_b16 v[218:219], v228 offset:26624
    ds_read_b64_tr_b16 v[220:221], v229 offset:24576
    ds_read_b64_tr_b16 v[222:223], v229 offset:26624
    s_cmp_eq_u32 s99, 1
    s_cbranch_scc1 L_ego
    s_waitcnt lgkmcnt(15)
    v_cmp_eq_u32 vcc, 0, v1
    s_cbranch_vccnz L_ebar
    s_barrier
L_ego:
    s_waitcnt vmcnt(6) lgkmcnt(15)
L_hchk0:
    v_max3_u32 v1, v16, v17, v18
    v_max_u32 v1, v1, v19
    v_cmp_eq_u32 vcc, -1, v1
    s_cbranch_vccnz L_hre0
L_hok0:
    v_mfma_f32_16x16x32_bf16 v[48:51], v[112:115], v[16:19], 0
    v_mfma_f32_16x16x32_bf16 v[52:55], v[116:119], v[16:19], 0
    v_mfma_f32_16x16x32_bf16 v[56:59], v[120:123], v[16:19], 0
    v_mfma_f32_16x16x32_bf16 v[60:63], v[124:127], v[16:19], 0
    s_waitcnt vmcnt(5) lgkmcnt(15)
L_hchk1:
    v_max3_u32 v1, v20, v21, v22
    v_max_u32 v1, v1, v23
    v_cmp_eq_u32 vcc, -1, v1
    s_cbranch_vccnz L_hre1
L_hok1:
    v_mfma_f32_16x16x32_bf16 v[48:51], v[128:131], v[20:23], v[48:51]
    v_mfma_f32_16x16x32_bf16 v[52:55], v[132:135], v[20:23], v[52:55]
    v_mfma_f32_16x16x32_bf16 v[56:59], v[136:139], v[20:23], v[56:59]
    v_mfma_f32_16x16x32_bf16 v[60:63], v[140:143], v[20:23], v[60:63]
    s_waitcnt vmcnt(4) lgkmcnt(15)
L_hchk2:
    v_max3_u32 v1, v24, v25, v26
    v_max_u32 v1, v1, v27
    v_cmp_eq_u32 vcc, -1, v1
    s_cbranch_vccnz L_hre2
L_hok2:
    v_mfma_f32_16x16x32_bf16 v[48:51], v[144:147], v[24:27], v[48:51]
    v_mfma_f32_16x16x32_bf16 v[52:55], v[148:151], v[24:27], v[52:55]
    v_mfma_f32_16x16x32_bf16 v[56:59], v[152:155], v[24:27], v[56:59]
    v_mfma_f32_16x16x32_bf16 v[60:63], v[156:159], v[24:27], v[60:63]
    s_waitcnt vmcnt(3) lgkmcnt(15)
L_hchk3:
    v_max3_u32 v1, v28, v29, v30
    v_max_u32 v1, v1, v31
    v_cmp_eq_u32 vcc, -1, v1
    s_cbranch_vccnz L_hre3
L_hok3:
    v_mfma_f32_16x16x32_bf16 v[48:51], v[160:163], v[28:31], v[48:51]
    v_mfma_f32_16x16x32_bf16 v[52:55], v[164:167], v[28:31], v[52:55]
    v_mfma_f32_16x16x32_bf16 v[56:59], v[168:171], v[28:31], v[56:59]
    v_mfma_f32_16x16x32_bf16 v[60:63], v[172:175], v[28:31], v[60:63]
    s_waitcnt vmcnt(2) lgkmcnt(15)
L_hchk4:
    v_max3_u32 v1, v32, v33, v34
    v_max_u32 v1, v1, v35
    v_cmp_eq_u32 vcc, -1, v1
    s_cbranch_vccnz L_hre4
L_hok4:
    v_mfma_f32_16x16x32_bf16 v[48:51], v[176:179], v[32:35], v[48:51]
    v_mfma_f32_16x16x32_bf16 v[52:55], v[180:183], v[32:35], v[52:55]
    v_mfma_f32_16x16x32_bf16 v[56:59], v[184:187], v[32:35], v[56:59]
    v_mfma_f32_16x16x32_bf16 v[60:63], v[188:191], v[32:35], v[60:63]
    s_waitcnt vmcnt(1) lgkmcnt(8)
L_hchk5:
    v_max3_u32 v1, v36, v37, v38
    v_max_u32 v1, v1, v39
    v_cmp_eq_u32 vcc, -1, v1
    s_cbranch_vccnz L_hre5
L_hok5:
    v_mfma_f32_16x16x32_bf16 v[48:51], v[192:195], v[36:39], v[48:51]
    v_mfma_f32_16x16x32_bf16 v[52:55], v[196:199], v[36:39], v[52:55]
    v_mfma_f32_16x16x32_bf16 v[56:59], v[200:203], v[36:39], v[56:59]
    v_mfma_f32_16x16x32_bf16 v[60:63], v[204:207], v[36:39], v[60:63]
    s_waitcnt vmcnt(0) lgkmcnt(0)
L_hchk6:
    v_max3_u32 v1, v40, v41, v42
    v_max_u32 v1, v1, v43
    v_cmp_eq_u32 vcc, -1, v1
    s_cbranch_vccnz L_hre6
L_hok6:
    v_mfma_f32_16x16x32_bf16 v[48:51], v[208:211], v[40:43], v[48:51]
    v_mfma_f32_16x16x32_bf16 v[52:55], v[212:215], v[40:43], v[52:55]
    v_mfma_f32_16x16x32_bf16 v[56:59], v[216:219], v[40:43], v[56:59]
    v_mfma_f32_16x16x32_bf16 v[60:63], v[220:223], v[40:43], v[60:63]
    s_nop 6
    ds_write_b128 v236, v[56:59]
    ds_write_b128 v236, v[60:63] offset:1024
    ds_write_b32 v15, v14 offset:16
L_xld:
    ds_read_b32 v24, v224
    ds_read_b128 v[16:19], v237
    ds_read_b128 v[20:23], v237 offset:1024
    s_waitcnt lgkmcnt(2)
    v_cmp_eq_u32 vcc, 0, v24
    s_cbranch_vccnz L_xre
L_xok:
    s_waitcnt lgkmcnt(1)
    v_pk_add_f32 v[16:17], v[16:17], v[48:49]
    v_pk_add_f32 v[18:19], v[18:19], v[50:51]
    v_min_u32 v16, -2, v16
    v_min_u32 v17, -2, v17
    v_min_u32 v18, -2, v18
    v_min_u32 v19, -2, v19
    buffer_store_dwordx4 v[16:19], v234, s[36:39], s90 offen sc1
    s_waitcnt lgkmcnt(0)
    v_pk_add_f32 v[20:21], v[20:21], v[52:53]
    v_pk_add_f32 v[22:23], v[22:23], v[54:55]
    v_min_u32 v20, -2, v20
    v_min_u32 v21, -2, v21
    v_min_u32 v22, -2, v22
    v_min_u32 v23, -2, v23
    buffer_store_dwordx4 v[20:23], v234, s[36:39], s91 offen sc1
    s_lshr_b32 s99, s19, 1
    s_lshl_b32 s99, s99, 30
    s_and_b32 s99, s99, 0x40000000
    v_or_b32 v233, s99, v233
    buffer_load_dword v3, off, s[12:15], 0 offset:128 sc1
    s_mov_b32 s99, 0
    s_cmp_lg_u32 s3, 0
    s_cbranch_scc1 L_xw
L_rld:
    buffer_load_dwordx4 v[64:67], v234, s[36:39], s92 offen offset:0 sc1
    buffer_load_dwordx4 v[68:71], v234, s[36:39], s92 offen offset:2048 sc1
    buffer_load_dwordx4 v[72:75], v234, s[36:39], s93 offen offset:0 sc1
    buffer_load_dwordx4 v[76:79], v234, s[36:39], s93 offen offset:2048 sc1
    buffer_load_dwordx4 v[80:83], v234, s[36:39], s4 offen offset:0 sc1
    buffer_load_dwordx4 v[84:87], v234, s[36:39], s4 offen offset:2048 sc1
    buffer_load_dwordx4 v[88:91], v234, s[36:39], s5 offen offset:0 sc1
    buffer_load_dwordx4 v[92:95], v234, s[36:39], s5 offen offset:2048 sc1
    s_waitcnt vmcnt(6)
    v_max3_u32 v1, v64, v65, v66
    v_max3_u32 v1, v1, v67, v68
    v_max3_u32 v1, v1, v69, v70
    v_max_u32 v1, v1, v71
    v_pk_add_f32 v[24:25], v[64:65], v[68:69]
    v_pk_add_f32 v[26:27], v[66:67], v[70:71]
    s_waitcnt vmcnt(4)
    v_max3_u32 v1, v1, v72, v73
    v_max3_u32 v1, v1, v74, v75
    v_max3_u32 v1, v1, v76, v77
    v_max3_u32 v1, v1, v78, v79
    v_pk_add_f32 v[28:29], v[72:73], v[76:77]
    v_pk_add_f32 v[30:31], v[74:75], v[78:79]
    s_waitcnt vmcnt(2)
    v_max3_u32 v1, v1, v80, v81
    v_max3_u32 v1, v1, v82, v83
    v_max3_u32 v1, v1, v84, v85
    v_max3_u32 v1, v1, v86, v87
    v_pk_add_f32 v[32:33], v[80:81], v[84:85]
    v_pk_add_f32 v[34:35], v[82:83], v[86:87]
    s_waitcnt vmcnt(0)
    v_max3_u32 v1, v1, v88, v89
    v_max3_u32 v1, v1, v90, v91
    v_max3_u32 v1, v1, v92, v93
    v_max3_u32 v1, v1, v94, v95
    v_pk_add_f32 v[36:37], v[88:89], v[92:93]
    v_pk_add_f32 v[38:39], v[90:91], v[94:95]
    v_cmp_ne_u32 vcc, 0, v3
    s_cbranch_vccnz L_xr
L_xr1:
    v_cmp_eq_u32 vcc, -1, v1
    s_cbranch_vccnz L_rre
L_rok:
    v_pk_add_f32 v[24:25], v[24:25], v[28:29]
    v_pk_add_f32 v[26:27], v[26:27], v[30:31]
    v_pk_add_f32 v[32:33], v[32:33], v[36:37]
    v_pk_add_f32 v[34:35], v[34:35], v[38:39]
    v_pk_add_f32 v[24:25], v[24:25], v[32:33]
    v_pk_add_f32 v[26:27], v[26:27], v[34:35]
    v_cvt_pk_bf16_f32 v24, v24, v25
    v_cvt_pk_bf16_f32 v25, v26, v27
    buffer_store_dwordx2 v[24:25], v238, s[44:47], s94 offen
L_fin:
    s_endpgm
L_helper:
    s_memrealtime s[4:5]
    s_cmp_eq_u32 s2, 224
    s_cselect_b32 s6, 8, 0
    s_cmp_eq_u32 s3, 0
    s_cselect_b32 s6, s6, 0
    v_lshlrev_b32 v13, 4, v0
    v_mov_b32 v3, 0x40000000
    v_cmp_gt_u32 vcc, s6, v0
    s_nop 1
    v_cndmask_b32 v13, v3, v13, vcc
    s_waitcnt lgkmcnt(0)
    s_or_b32 s5, s5, 0x80000000
    v_mov_b32 v28, s4
    v_mov_b32 v29, s5
    v_mov_b32 v30, s4
    v_mov_b32 v31, s5
    buffer_store_dwordx4 v[28:31], v13, s[12:15], 0 offen sc1
    v_lshlrev_b32 v12, 4, v0
    v_mov_b32 v16, -1
    v_mov_b32 v17, -1
    v_mov_b32 v18, -1
    v_mov_b32 v19, -1
    s_cmp_lg_u32 s19, 28
    s_cbranch_scc1 L_hpart
    s_mul_i32 s56, s3, 112
    s_mul_i32 s57, s18, 14
    s_add_u32 s56, s56, s57
    s_lshl_b32 s56, s56, 11
    s_add_u32 s56, s56, 0
    s_add_u32 s57, s56, 4096
    s_add_u32 s58, s56, 8192
    s_add_u32 s59, s56, 12288
    s_waitcnt lgkmcnt(0)
    buffer_store_dwordx4 v[16:19], v12, s[36:39], s56 offen offset:0 sc1
    buffer_store_dwordx4 v[16:19], v12, s[36:39], s56 offen offset:1024 sc1
    buffer_store_dwordx4 v[16:19], v12, s[36:39], s56 offen offset:2048 sc1
    buffer_store_dwordx4 v[16:19], v12, s[36:39], s56 offen offset:3072 sc1
    buffer_store_dwordx4 v[16:19], v12, s[36:39], s57 offen offset:0 sc1
    buffer_store_dwordx4 v[16:19], v12, s[36:39], s57 offen offset:1024 sc1
    buffer_store_dwordx4 v[16:19], v12, s[36:39], s57 offen offset:2048 sc1
    buffer_store_dwordx4 v[16:19], v12, s[36:39], s57 offen offset:3072 sc1
    buffer_store_dwordx4 v[16:19], v12, s[36:39], s58 offen offset:0 sc1
    buffer_store_dwordx4 v[16:19], v12, s[36:39], s58 offen offset:1024 sc1
    buffer_store_dwordx4 v[16:19], v12, s[36:39], s58 offen offset:2048 sc1
    buffer_store_dwordx4 v[16:19], v12, s[36:39], s58 offen offset:3072 sc1
    buffer_store_dwordx4 v[16:19], v12, s[36:39], s59 offen offset:0 sc1
    buffer_store_dwordx4 v[16:19], v12, s[36:39], s59 offen offset:1024 sc1
    buffer_store_dwordx4 v[16:19], v12, s[36:39], s59 offen offset:2048 sc1
    buffer_store_dwordx4 v[16:19], v12, s[36:39], s59 offen offset:3072 sc1
    s_add_u32 s56, s56, 16384
    s_add_u32 s57, s57, 16384
    s_add_u32 s58, s58, 16384
    buffer_store_dwordx4 v[16:19], v12, s[36:39], s56 offen offset:0 sc1
    buffer_store_dwordx4 v[16:19], v12, s[36:39], s56 offen offset:1024 sc1
    buffer_store_dwordx4 v[16:19], v12, s[36:39], s56 offen offset:2048 sc1
    buffer_store_dwordx4 v[16:19], v12, s[36:39], s56 offen offset:3072 sc1
    buffer_store_dwordx4 v[16:19], v12, s[36:39], s57 offen offset:0 sc1
    buffer_store_dwordx4 v[16:19], v12, s[36:39], s57 offen offset:1024 sc1
    buffer_store_dwordx4 v[16:19], v12, s[36:39], s57 offen offset:2048 sc1
    buffer_store_dwordx4 v[16:19], v12, s[36:39], s57 offen offset:3072 sc1
    buffer_store_dwordx4 v[16:19], v12, s[36:39], s58 offen offset:0 sc1
    buffer_store_dwordx4 v[16:19], v12, s[36:39], s58 offen offset:1024 sc1
    buffer_store_dwordx4 v[16:19], v12, s[36:39], s58 offen offset:2048 sc1
    buffer_store_dwordx4 v[16:19], v12, s[36:39], s58 offen offset:3072 sc1
    s_waitcnt vmcnt(0)
    s_barrier
    s_branch L_hcom
L_hpart:
    s_sub_u32 s52, s2, 232
    s_lshl_b32 s52, s52, 2
    s_add_u32 s52, s52, s3
    s_mul_i32 s52, s52, 22
    s_min_u32 s52, s52, 2026
    s_lshl_b32 s55, s52, 11
    s_add_u32 s55, s55, 1048576
    v_add_u32 v2, 640, v12
    v_lshrrev_b32 v2, 10, v2
    v_lshl_add_u32 v12, v2, 7, v12
    s_waitcnt lgkmcnt(0)
    buffer_store_dwordx4 v[16:19], v12, s[36:39], s55 offen offset:0 sc1
    buffer_store_dwordx4 v[16:19], v12, s[36:39], s55 offen offset:2048 sc1
    s_add_u32 s55, s55, 4096
    buffer_store_dwordx4 v[16:19], v12, s[36:39], s55 offen offset:0 sc1
    buffer_store_dwordx4 v[16:19], v12, s[36:39], s55 offen offset:2048 sc1
    s_add_u32 s55, s55, 4096
    buffer_store_dwordx4 v[16:19], v12, s[36:39], s55 offen offset:0 sc1
    buffer_store_dwordx4 v[16:19], v12, s[36:39], s55 offen offset:2048 sc1
    s_add_u32 s55, s55, 4096
    buffer_store_dwordx4 v[16:19], v12, s[36:39], s55 offen offset:0 sc1
    buffer_store_dwordx4 v[16:19], v12, s[36:39], s55 offen offset:2048 sc1
    s_add_u32 s55, s55, 4096
    buffer_store_dwordx4 v[16:19], v12, s[36:39], s55 offen offset:0 sc1
    buffer_store_dwordx4 v[16:19], v12, s[36:39], s55 offen offset:2048 sc1
    s_add_u32 s55, s55, 4096
    buffer_store_dwordx4 v[16:19], v12, s[36:39], s55 offen offset:0 sc1
    buffer_store_dwordx4 v[16:19], v12, s[36:39], s55 offen offset:2048 sc1
    s_add_u32 s55, s55, 4096
    buffer_store_dwordx4 v[16:19], v12, s[36:39], s55 offen offset:0 sc1
    buffer_store_dwordx4 v[16:19], v12, s[36:39], s55 offen offset:2048 sc1
    s_add_u32 s55, s55, 4096
    buffer_store_dwordx4 v[16:19], v12, s[36:39], s55 offen offset:0 sc1
    buffer_store_dwordx4 v[16:19], v12, s[36:39], s55 offen offset:2048 sc1
    s_add_u32 s55, s55, 4096
    buffer_store_dwordx4 v[16:19], v12, s[36:39], s55 offen offset:0 sc1
    buffer_store_dwordx4 v[16:19], v12, s[36:39], s55 offen offset:2048 sc1
    s_add_u32 s55, s55, 4096
    buffer_store_dwordx4 v[16:19], v12, s[36:39], s55 offen offset:0 sc1
    buffer_store_dwordx4 v[16:19], v12, s[36:39], s55 offen offset:2048 sc1
    s_add_u32 s55, s55, 4096
    buffer_store_dwordx4 v[16:19], v12, s[36:39], s55 offen offset:0 sc1
    buffer_store_dwordx4 v[16:19], v12, s[36:39], s55 offen offset:2048 sc1
    s_waitcnt vmcnt(0)
    s_barrier
L_hcom:
    s_lshr_b32 s82, s19, 1
    s_and_b32 s83, s19, 1
    s_mul_i32 s80, s18, 917504
    s_lshl_b32 s86, s82, 7
    s_add_u32 s80, s80, s86
    v_lshrrev_b32 v2, 3, v0
    v_lshlrev_b32 v20, 11, v2
    v_and_b32 v3, 7, v0
    v_bfe_u32 v4, v0, 4, 2
    v_lshlrev_b32 v4, 1, v4
    v_xor_b32 v3, v3, v4
    v_lshl_add_u32 v20, v3, 4, v20
    s_lshl_b32 s84, s83, 1
    s_add_u32 s84, s84, s3
    s_and_b32 s84, s84, 3
    s_mul_i32 s84, s84, 14
    s_lshl_b32 s86, s84, 10
    s_add_u32 s86, s86, 81920
    s_lshl_b32 s88, s84, 14
    s_add_u32 s88, s88, s80
    s_add_u32 m0, s86, 0
    s_add_u32 s90, s88, 0
    buffer_load_dwordx4 v20, s[32:35], s90 offen lds
    s_add_u32 m0, s86, 1024
    s_add_u32 s90, s88, 16384
    buffer_load_dwordx4 v20, s[32:35], s90 offen lds
    s_add_u32 m0, s86, 2048
    s_add_u32 s90, s88, 32768
    buffer_load_dwordx4 v20, s[32:35], s90 offen lds
    s_add_u32 m0, s86, 3072
    s_add_u32 s90, s88, 49152
    buffer_load_dwordx4 v20, s[32:35], s90 offen lds
    s_add_u32 m0, s86, 4096
    s_add_u32 s90, s88, 65536
    buffer_load_dwordx4 v20, s[32:35], s90 offen lds
    s_add_u32 m0, s86, 5120
    s_add_u32 s90, s88, 81920
    buffer_load_dwordx4 v20, s[32:35], s90 offen lds
    s_add_u32 m0, s86, 6144
    s_add_u32 s90, s88, 98304
    buffer_load_dwordx4 v20, s[32:35], s90 offen lds
    s_add_u32 m0, s86, 7168
    s_add_u32 s90, s88, 114688
    buffer_load_dwordx4 v20, s[32:35], s90 offen lds
    s_add_u32 m0, s86, 8192
    s_add_u32 s90, s88, 131072
    buffer_load_dwordx4 v20, s[32:35], s90 offen lds
    s_add_u32 m0, s86, 9216
    s_add_u32 s90, s88, 147456
    buffer_load_dwordx4 v20, s[32:35], s90 offen lds
    s_add_u32 m0, s86, 10240
    s_add_u32 s90, s88, 163840
    buffer_load_dwordx4 v20, s[32:35], s90 offen lds
    s_add_u32 m0, s86, 11264
    s_add_u32 s90, s88, 180224
    buffer_load_dwordx4 v20, s[32:35], s90 offen lds
    s_add_u32 m0, s86, 12288
    s_add_u32 s90, s88, 196608
    buffer_load_dwordx4 v20, s[32:35], s90 offen lds
    s_add_u32 m0, s86, 13312
    s_add_u32 s90, s88, 212992
    buffer_load_dwordx4 v20, s[32:35], s90 offen lds
    s_mov_b32 s96, 131072
    s_mov_b32 s97, 1048576
    s_lshr_b32 s82, s19, 1
    s_and_b32 s83, s19, 1
    s_and_b32 s84, s3, 1
    s_lshr_b32 s85, s3, 1
    v_lshlrev_b32 v225, 4, v0
    s_mul_i32 s86, s84, 28672
    s_add_u32 s86, s86, 81920
    s_lshl_b32 s87, s84, 6
    v_lshrrev_b32 v2, 4, v0
    v_bfe_u32 v3, v0, 2, 2
    v_lshlrev_b32 v4, 2, v2
    v_add_u32 v4, v4, v3
    v_lshlrev_b32 v4, 7, v4
    v_and_b32 v5, 3, v0
    v_lshl_add_u32 v4, v5, 3, v4
    v_bfe_u32 v5, v0, 3, 2
    v_lshlrev_b32 v5, 5, v5
    v_xor_b32 v5, s87, v5
    v_add_u32 v4, s86, v4
    v_add_u32 v226, v4, v5
    v_xor_b32 v3, 32, v5
    v_add_u32 v227, v4, v3
    v_xor_b32 v3, 64, v5
    v_add_u32 v228, v4, v3
    v_xor_b32 v3, 96, v5
    v_add_u32 v229, v4, v3
    s_lshl_b32 s86, s83, 1
    s_add_u32 s86, s86, s85
    s_mul_i32 s86, s86, 112
    s_mul_i32 s87, s18, 14
    s_add_u32 s86, s86, s87
    s_mul_i32 s87, s84, 7
    s_add_u32 s86, s86, s87
    s_lshl_b32 s88, s86, 11
    s_add_u32 s88, s88, 0
    s_add_u32 s89, s88, 4096
    s_add_u32 s6, s88, 8192
    s_add_u32 s7, s88, 12288
    s_mov_b32 s98, 0xffff0000
    s_add_u32 s86, s53, 8192
    v_add_u32 v236, s86, v225
    s_xor_b32 s86, s3, 1
    s_mul_i32 s86, s86, 20480
    s_add_u32 s86, s86, 8192
    v_add_u32 v237, s86, v225
    s_lshl_b32 s81, s83, 4
    s_add_u32 s81, s81, s82
    s_lshl_b32 s86, s81, 3
    s_lshl_b32 s87, s3, 1
    s_add_u32 s86, s86, s87
    s_lshl_b32 s86, s86, 3
    s_add_u32 s86, s86, s18
    s_lshl_b32 s90, s86, 11
    s_add_u32 s90, s90, 1048576
    s_add_u32 s91, s90, 16384
    v_add_u32 v2, 640, v225
    v_lshrrev_b32 v2, 10, v2
    v_lshl_add_u32 v234, v2, 7, v225
    s_lshl_b32 s92, s81, 3
    s_add_u32 s92, s92, s18
    s_lshl_b32 s92, s92, 14
    s_add_u32 s92, s92, 1048576
    s_add_u32 s93, s92, 4096
    s_add_u32 s4, s92, 8192
    s_add_u32 s5, s92, 12288
    s_lshl_b32 s94, s83, 1
    s_lshr_b32 s95, s18, 2
    s_add_u32 s94, s94, s95
    s_lshl_b32 s94, s94, 15
    s_lshl_b32 s95, s82, 7
    s_add_u32 s94, s94, s95
    s_and_b32 s95, s18, 3
    s_lshl_b32 s95, s95, 5
    s_add_u32 s94, s94, s95
    v_and_b32 v2, 15, v0
    v_lshlrev_b32 v238, 11, v2
    v_lshrrev_b32 v2, 4, v0
    v_lshl_add_u32 v238, v2, 3, v238
    v_mov_b32 v239, 147456
    s_lshl_b32 s95, s3, 2
    v_add_u32 v15, s95, v239
    v_xor_b32 v224, 20, v15
    v_mov_b32 v14, 1
    v_mov_b32 v233, 0x40000000
    s_mov_b32 s62, 0
    s_waitcnt vmcnt(0)
    s_barrier
    ds_write_b32 v239, v14 offset:32
    s_branch L_p2
L_service:
    s_getreg_b32 s9, hwreg(HW_REG_XCC_ID, 0, 4)
    s_cmp_eq_u32 s9, s18
    s_cbranch_scc1 L_home
    v_mov_b32 v2, 1
    s_waitcnt lgkmcnt(0)
    buffer_store_dword v2, off, s[12:15], 0 offset:128 sc1
    s_waitcnt vmcnt(0)
L_home:
    v_lshlrev_b32 v2, 7, v0
    v_lshrrev_b32 v3, 5, v0
    v_lshl_or_b32 v2, v3, 30, v2
    s_lshl_b32 s56, s19, 12
    s_waitcnt lgkmcnt(0)
    buffer_load_dword v15, v2, s[20:23], s56 offen
    s_memrealtime s[4:5]
    v_mov_b32 v233, 0x40000000
    s_lshr_b32 s82, s19, 1
    s_and_b32 s83, s19, 1
    s_mul_i32 s80, s18, 917504
    s_lshl_b32 s86, s82, 7
    s_add_u32 s80, s80, s86
    v_lshrrev_b32 v2, 3, v0
    v_lshlrev_b32 v224, 11, v2
    v_and_b32 v3, 7, v0
    v_bfe_u32 v4, v0, 4, 2
    v_lshlrev_b32 v4, 1, v4
    v_xor_b32 v3, v3, v4
    v_lshl_add_u32 v224, v3, 4, v224
    v_mov_b32 v8, 0
    v_mov_b32 v9, 0
    v_mov_b32 v10, 0
    v_mov_b32 v11, 0
    v_mov_b32 v12, 147456
    ds_write_b128 v12, v[8:11]
    ds_write_b128 v12, v[8:11] offset:16
    ds_write_b128 v12, v[8:11] offset:32
    s_mul_i32 s84, s83, 28
    s_sub_u32 s85, 28, s84
    s_lshl_b32 s86, s84, 10
    s_add_u32 s86, s86, 81920
    s_lshl_b32 s87, s85, 10
    s_add_u32 s87, s87, 81920
    s_lshl_b32 s88, s84, 14
    s_add_u32 s88, s88, s80
    s_lshl_b32 s89, s85, 14
    s_add_u32 s89, s89, s80
    s_mov_b32 s96, 131072
    s_lshl_b32 s92, s18, 7
    s_add_u32 s92, s92, 921600
    v_lshlrev_b32 v13, 4, v0
    v_cmp_gt_u32 vcc, 8, v0
    s_nop 1
    v_cndmask_b32 v13, v233, v13, vcc
    s_waitcnt lgkmcnt(0)
    s_cmp_lt_u32 s19, 28
    s_cbranch_scc1 L_svc0
    s_sub_u32 s48, s19, 28
    s_cmp_lg_u32 s2, 9999
    s_cbranch_scc1 L_nonon
    s_or_b32 s5, s5, 0x80000000
    v_mov_b32 v28, s4
    v_mov_b32 v29, s5
    v_mov_b32 v30, s4
    v_mov_b32 v31, s5
    buffer_store_dwordx4 v[28:31], v13, s[12:15], 0 offen sc1
L_nonon:
    s_add_u32 s50, s18, 3
    s_and_b32 s50, s50, 7
    s_mul_i32 s51, s18, 7
    s_add_u32 s51, s51, s50
    s_lshl_b32 s51, s51, 7
    s_lshl_b32 s52, s48, 1
    s_add_u32 s52, s52, 1
    s_mul_i32 s52, s52, 229376
    s_add_u32 s51, s51, s52
    s_add_u32 s52, s51, 3670016
    v_and_b32 v2, 31, v0
    v_lshrrev_b32 v3, 5, v0
    v_lshl_add_u32 v2, v3, 8, v2
    v_mul_u32_u24 v14, 7168, v2
    s_cmp_eq_u32 s50, 7
    s_cselect_b32 s50, 0x40000000, 0
    v_or_b32 v14, s50, v14
    buffer_load_dword v20, v14, s[24:27], s51 offen
    buffer_load_dword v21, v14, s[28:31], s51 offen
    buffer_load_dword v22, v14, s[24:27], s52 offen
    buffer_load_dword v23, v14, s[28:31], s52 offen
    s_mov_b32 s8, 32
L_sn:
    s_load_dwordx2 s[6:7], s[12:13], 0 glc
    s_sub_u32 s8, s8, 1
    s_cbranch_scc1 L_hn
    s_waitcnt lgkmcnt(0)
    s_cmp_eq_u32 s7, 0
    s_cbranch_scc1 L_sn
    v_mov_b32 v32, s6
    v_mov_b32 v33, s7
    s_branch L_hn1
L_hn:
    buffer_load_dwordx2 v[32:33], off, s[12:15], 0 sc1
    s_waitcnt vmcnt(0)
    v_cmp_eq_u32 vcc, 0, v33
    s_cbranch_vccz L_hn1
    s_cmp_eq_u32 s96, 0
    s_cbranch_scc1 L_hn1
    s_sub_u32 s96, s96, 1
    s_sleep 4
    s_branch L_hn
L_hn1:
    v_mov_b32 v34, 0
    v_mov_b32 v35, 0
    s_sub_u32 s93, s2, 232
    s_lshl_b32 s93, s93, 7
    s_add_u32 s93, s93, 917504
    s_cmp_eq_u32 s48, 0
    s_cselect_b32 s93, s92, s93
    s_barrier
    buffer_store_dwordx4 v[32:35], v13, s[36:39], s93 offen sc1
    s_cmp_lg_u32 s48, 0
    s_cbranch_scc1 L_late
    s_waitcnt vmcnt(0)
    buffer_load_dwordx4 v[36:39], off, s[36:39], s92 sc1
    v_min_u32 v2, 23, v0
    v_lshlrev_b32 v2, 7, v2
    s_mov_b32 s93, 917504
L_mf:
    buffer_load_dwordx2 v[40:41], v2, s[36:39], s93 offen sc1
    s_waitcnt vmcnt(0)
    v_cmp_ne_u64 vcc, v[32:33], v[40:41]
    s_cbranch_vccz L_mf1
    s_cmp_eq_u32 s96, 0
    s_cbranch_scc1 L_mf1
    s_sub_u32 s96, s96, 1
    s_sleep 4
    s_branch L_mf
L_mf1:
    v_mov_b32 v34, 1
    buffer_store_dwordx4 v[32:35], v13, s[36:39], s92 offen sc1
    s_waitcnt vmcnt(0)
    buffer_load_dwordx4 v[36:39], off, s[36:39], s92 sc1
L_late:
    s_lshr_b32 s55, s48, 1
    s_lshl_b32 s55, s55, 10
    s_add_u32 s55, s55, 384
    s_and_b32 s56, s48, 1
    s_mul_i32 s56, s56, 458752
    s_add_u32 s55, s55, s56
    s_mul_i32 s56, s18, 917504
    s_add_u32 s55, s55, s56
    v_min_u32 v2, 55, v0
    v_lshlrev_b32 v2, 11, v2
    buffer_load_dword v24, v2, s[32:35], s55 offen
    s_add_u32 s55, s55, 114688
    buffer_load_dword v25, v2, s[32:35], s55 offen
    s_add_u32 s55, s55, 114688
    buffer_load_dword v26, v2, s[32:35], s55 offen
    s_add_u32 s55, s55, 114688
    buffer_load_dword v27, v2, s[32:35], s55 offen
    s_add_u32 s55, s55, 114688
    s_branch L_svcr
L_svc0:
    s_barrier
L_svcp:
    buffer_load_dwordx2 v[32:33], off, s[12:15], 0 sc1
    buffer_load_dwordx4 v[36:39], off, s[36:39], s92 sc1
    s_waitcnt vmcnt(0)
    v_cmp_ne_u64 vcc, v[32:33], v[36:37]
    v_cmp_eq_u32 s[94:95], 0, v33
    s_nop 1
    s_or_b64 vcc, vcc, s[94:95]
    s_cbranch_vccz L_svcb
    s_cmp_eq_u32 s96, 0
    s_cbranch_scc1 L_svcb
    s_sub_u32 s96, s96, 1
    s_sleep 4
    s_branch L_svcp
L_svcb:
    s_barrier
L_svcq:
    s_add_u32 m0, s86, 0
    s_add_u32 s90, s88, 0
    buffer_load_dwordx4 v224, s[32:35], s90 offen lds
    s_add_u32 m0, s86, 1024
    s_add_u32 s90, s88, 16384
    buffer_load_dwordx4 v224, s[32:35], s90 offen lds
    s_add_u32 m0, s86, 2048
    s_add_u32 s90, s88, 32768
    buffer_load_dwordx4 v224, s[32:35], s90 offen lds
    s_add_u32 m0, s86, 3072
    s_add_u32 s90, s88, 49152
    buffer_load_dwordx4 v224, s[32:35], s90 offen lds
    s_add_u32 m0, s86, 4096
    s_add_u32 s90, s88, 65536
    buffer_load_dwordx4 v224, s[32:35], s90 offen lds
    s_add_u32 m0, s86, 5120
    s_add_u32 s90, s88, 81920
    buffer_load_dwordx4 v224, s[32:35], s90 offen lds
    s_add_u32 m0, s86, 6144
    s_add_u32 s90, s88, 98304
    buffer_load_dwordx4 v224, s[32:35], s90 offen lds
    s_add_u32 m0, s86, 7168
    s_add_u32 s90, s88, 114688
    buffer_load_dwordx4 v224, s[32:35], s90 offen lds
    s_add_u32 m0, s86, 8192
    s_add_u32 s90, s88, 131072
    buffer_load_dwordx4 v224, s[32:35], s90 offen lds
    s_add_u32 m0, s86, 9216
    s_add_u32 s90, s88, 147456
    buffer_load_dwordx4 v224, s[32:35], s90 offen lds
    s_add_u32 m0, s86, 10240
    s_add_u32 s90, s88, 163840
    buffer_load_dwordx4 v224, s[32:35], s90 offen lds
    s_add_u32 m0, s86, 11264
    s_add_u32 s90, s88, 180224
    buffer_load_dwordx4 v224, s[32:35], s90 offen lds
    s_add_u32 m0, s86, 12288
    s_add_u32 s90, s88, 196608
    buffer_load_dwordx4 v224, s[32:35], s90 offen lds
    s_add_u32 m0, s86, 13312
    s_add_u32 s90, s88, 212992
    buffer_load_dwordx4 v224, s[32:35], s90 offen lds
    s_add_u32 m0, s86, 14336
    s_add_u32 s90, s88, 229376
    buffer_load_dwordx4 v224, s[32:35], s90 offen lds
    s_add_u32 m0, s86, 15360
    s_add_u32 s90, s88, 245760
    buffer_load_dwordx4 v224, s[32:35], s90 offen lds
    s_add_u32 m0, s86, 16384
    s_add_u32 s90, s88, 262144
    buffer_load_dwordx4 v224, s[32:35], s90 offen lds
    s_add_u32 m0, s86, 17408
    s_add_u32 s90, s88, 278528
    buffer_load_dwordx4 v224, s[32:35], s90 offen lds
    s_add_u32 m0, s86, 18432
    s_add_u32 s90, s88, 294912
    buffer_load_dwordx4 v224, s[32:35], s90 offen lds
    s_add_u32 m0, s86, 19456
    s_add_u32 s90, s88, 311296
    buffer_load_dwordx4 v224, s[32:35], s90 offen lds
    s_add_u32 m0, s86, 20480
    s_add_u32 s90, s88, 327680
    buffer_load_dwordx4 v224, s[32:35], s90 offen lds
    s_add_u32 m0, s86, 21504
    s_add_u32 s90, s88, 344064
    buffer_load_dwordx4 v224, s[32:35], s90 offen lds
    s_add_u32 m0, s86, 22528
    s_add_u32 s90, s88, 360448
    buffer_load_dwordx4 v224, s[32:35], s90 offen lds
    s_add_u32 m0, s86, 23552
    s_add_u32 s90, s88, 376832
    buffer_load_dwordx4 v224, s[32:35], s90 offen lds
    s_add_u32 m0, s86, 24576
    s_add_u32 s90, s88, 393216
    buffer_load_dwordx4 v224, s[32:35], s90 offen lds
    s_add_u32 m0, s86, 25600
    s_add_u32 s90, s88, 409600
    buffer_load_dwordx4 v224, s[32:35], s90 offen lds
    s_add_u32 m0, s86, 26624
    s_add_u32 s90, s88, 425984
    buffer_load_dwordx4 v224, s[32:35], s90 offen lds
    s_add_u32 m0, s86, 27648
    s_add_u32 s90, s88, 442368
    buffer_load_dwordx4 v224, s[32:35], s90 offen lds
    s_add_u32 m0, s87, 0
    s_add_u32 s90, s89, 0
    buffer_load_dwordx4 v224, s[32:35], s90 offen lds
    s_add_u32 m0, s87, 1024
    s_add_u32 s90, s89, 16384
    buffer_load_dwordx4 v224, s[32:35], s90 offen lds
    s_add_u32 m0, s87, 2048
    s_add_u32 s90, s89, 32768
    buffer_load_dwordx4 v224, s[32:35], s90 offen lds
    s_add_u32 m0, s87, 3072
    s_add_u32 s90, s89, 49152
    buffer_load_dwordx4 v224, s[32:35], s90 offen lds
    s_add_u32 m0, s87, 4096
    s_add_u32 s90, s89, 65536
    buffer_load_dwordx4 v224, s[32:35], s90 offen lds
    s_add_u32 m0, s87, 5120
    s_add_u32 s90, s89, 81920
    buffer_load_dwordx4 v224, s[32:35], s90 offen lds
    s_add_u32 m0, s87, 6144
    s_add_u32 s90, s89, 98304
    buffer_load_dwordx4 v224, s[32:35], s90 offen lds
    s_add_u32 m0, s87, 7168
    s_add_u32 s90, s89, 114688
    buffer_load_dwordx4 v224, s[32:35], s90 offen lds
    s_add_u32 m0, s87, 8192
    s_add_u32 s90, s89, 131072
    buffer_load_dwordx4 v224, s[32:35], s90 offen lds
    s_add_u32 m0, s87, 9216
    s_add_u32 s90, s89, 147456
    buffer_load_dwordx4 v224, s[32:35], s90 offen lds
    s_add_u32 m0, s87, 10240
    s_add_u32 s90, s89, 163840
    buffer_load_dwordx4 v224, s[32:35], s90 offen lds
    s_add_u32 m0, s87, 11264
    s_add_u32 s90, s89, 180224
    buffer_load_dwordx4 v224, s[32:35], s90 offen lds
    s_add_u32 m0, s87, 12288
    s_add_u32 s90, s89, 196608
    buffer_load_dwordx4 v224, s[32:35], s90 offen lds
    s_add_u32 m0, s87, 13312
    s_add_u32 s90, s89, 212992
    buffer_load_dwordx4 v224, s[32:35], s90 offen lds
    s_add_u32 m0, s87, 14336
    s_add_u32 s90, s89, 229376
    buffer_load_dwordx4 v224, s[32:35], s90 offen lds
    s_add_u32 m0, s87, 15360
    s_add_u32 s90, s89, 245760
    buffer_load_dwordx4 v224, s[32:35], s90 offen lds
    s_add_u32 m0, s87, 16384
    s_add_u32 s90, s89, 262144
    buffer_load_dwordx4 v224, s[32:35], s90 offen lds
    s_add_u32 m0, s87, 17408
    s_add_u32 s90, s89, 278528
    buffer_load_dwordx4 v224, s[32:35], s90 offen lds
    s_add_u32 m0, s87, 18432
    s_add_u32 s90, s89, 294912
    buffer_load_dwordx4 v224, s[32:35], s90 offen lds
    s_add_u32 m0, s87, 19456
    s_add_u32 s90, s89, 311296
    buffer_load_dwordx4 v224, s[32:35], s90 offen lds
    s_add_u32 m0, s87, 20480
    s_add_u32 s90, s89, 327680
    buffer_load_dwordx4 v224, s[32:35], s90 offen lds
    s_add_u32 m0, s87, 21504
    s_add_u32 s90, s89, 344064
    buffer_load_dwordx4 v224, s[32:35], s90 offen lds
    s_add_u32 m0, s87, 22528
    s_add_u32 s90, s89, 360448
    buffer_load_dwordx4 v224, s[32:35], s90 offen lds
    s_add_u32 m0, s87, 23552
    s_add_u32 s90, s89, 376832
    buffer_load_dwordx4 v224, s[32:35], s90 offen lds
    s_add_u32 m0, s87, 24576
    s_add_u32 s90, s89, 393216
    buffer_load_dwordx4 v224, s[32:35], s90 offen lds
    s_add_u32 m0, s87, 25600
    s_add_u32 s90, s89, 409600
    buffer_load_dwordx4 v224, s[32:35], s90 offen lds
    s_add_u32 m0, s87, 26624
    s_add_u32 s90, s89, 425984
    buffer_load_dwordx4 v224, s[32:35], s90 offen lds
    s_add_u32 m0, s87, 27648
    s_add_u32 s90, s89, 442368
    buffer_load_dwordx4 v224, s[32:35], s90 offen lds
    s_waitcnt vmcnt(0)
    v_mov_b32 v1, 1
    ds_write_b32 v12, v1 offset:32
L_svcr:
    buffer_load_dwordx4 v[36:39], off, s[36:39], s92 sc1
    s_waitcnt vmcnt(0)
    v_cmp_ne_u64 vcc, v[32:33], v[36:37]
    v_cmp_ne_u32 s[94:95], 1, v38
    s_nop 1
    s_or_b64 vcc, vcc, s[94:95]
    s_cbranch_vccz L_svcs
    s_cmp_eq_u32 s96, 0
    s_cbranch_scc1 L_svcs
    s_sub_u32 s96, s96, 1
    s_sleep 4
    s_branch L_svcr
L_svcs:
    s_cmp_lt_u32 s19, 28
    s_cbranch_scc1 L_svct
    s_barrier
L_svct:
    s_barrier
    s_branch L_epi
L_lre:
    s_cmp_eq_u32 s97, 0
    s_cbranch_scc1 L_lok
    s_sub_u32 s97, s97, 1
    ds_read_b128 v[48:51], v239
    s_waitcnt lgkmcnt(0)
    v_min3_u32 v1, v48, v49, v50
    v_min_u32 v1, v1, v51
    v_cmp_eq_u32 vcc, 0, v1
    s_cbranch_vccnz L_lre
    ds_read_b128 v[16:19], v231 offset:0
    ds_read_b128 v[32:35], v231 offset:4096
    ds_read_b128 v[20:23], v231 offset:20480
    ds_read_b128 v[36:39], v231 offset:24576
    ds_read_b128 v[24:27], v232 offset:0
    ds_read_b128 v[40:43], v232 offset:4096
    ds_read_b128 v[28:31], v232 offset:20480
    ds_read_b128 v[44:47], v232 offset:24576
    s_branch L_lok
L_ure:
    s_cmp_eq_u32 s97, 0
    s_cbranch_scc1 L_uok
    s_sub_u32 s97, s97, 1
    buffer_load_dwordx4 v[52:55], v233, s[36:39], s62 offen offset:1024 sc1
    s_branch L_uchk
L_ufin:
    v_cvt_pk_bf16_f32 v240, v16, v17
    v_cvt_pk_bf16_f32 v241, v18, v19
    v_cvt_pk_bf16_f32 v242, v32, v33
    v_cvt_pk_bf16_f32 v243, v34, v35
    s_nop 1
    v_permlane32_swap_b32 v240, v242
    v_permlane32_swap_b32 v241, v243
    s_nop 1
    s_branch L_ucom
L_hre0:
    s_cmp_eq_u32 s96, 0
    s_cbranch_scc1 L_hok0
    s_sub_u32 s96, s96, 1
    s_cmp_gt_u32 s96, 131040
    s_cbranch_scc1 L_hnr0
    buffer_store_dwordx4 v[240:243], v233, s[36:39], s62 offen sc1
L_hnr0:
    buffer_load_dwordx4 v[16:19], v225, s[36:39], s88 offen offset:0 sc1
    buffer_load_dwordx4 v[20:23], v225, s[36:39], s88 offen offset:2048 sc1
    buffer_load_dwordx4 v[24:27], v225, s[36:39], s89 offen offset:0 sc1
    buffer_load_dwordx4 v[28:31], v225, s[36:39], s89 offen offset:2048 sc1
    buffer_load_dwordx4 v[32:35], v225, s[36:39], s6 offen offset:0 sc1
    buffer_load_dwordx4 v[36:39], v225, s[36:39], s6 offen offset:2048 sc1
    buffer_load_dwordx4 v[40:43], v225, s[36:39], s7 offen offset:0 sc1
    s_waitcnt vmcnt(6)
    s_branch L_hchk0
L_hre1:
    s_cmp_eq_u32 s96, 0
    s_cbranch_scc1 L_hok1
    s_sub_u32 s96, s96, 1
    s_cmp_gt_u32 s96, 131040
    s_cbranch_scc1 L_hnr1
    buffer_store_dwordx4 v[240:243], v233, s[36:39], s62 offen sc1
L_hnr1:
    buffer_load_dwordx4 v[20:23], v225, s[36:39], s88 offen offset:2048 sc1
    buffer_load_dwordx4 v[24:27], v225, s[36:39], s89 offen offset:0 sc1
    buffer_load_dwordx4 v[28:31], v225, s[36:39], s89 offen offset:2048 sc1
    buffer_load_dwordx4 v[32:35], v225, s[36:39], s6 offen offset:0 sc1
    buffer_load_dwordx4 v[36:39], v225, s[36:39], s6 offen offset:2048 sc1
    buffer_load_dwordx4 v[40:43], v225, s[36:39], s7 offen offset:0 sc1
    s_waitcnt vmcnt(5)
    s_branch L_hchk1
L_hre2:
    s_cmp_eq_u32 s96, 0
    s_cbranch_scc1 L_hok2
    s_sub_u32 s96, s96, 1
    s_cmp_gt_u32 s96, 131040
    s_cbranch_scc1 L_hnr2
    buffer_store_dwordx4 v[240:243], v233, s[36:39], s62 offen sc1
L_hnr2:
    buffer_load_dwordx4 v[24:27], v225, s[36:39], s89 offen offset:0 sc1
    buffer_load_dwordx4 v[28:31], v225, s[36:39], s89 offen offset:2048 sc1
    buffer_load_dwordx4 v[32:35], v225, s[36:39], s6 offen offset:0 sc1
    buffer_load_dwordx4 v[36:39], v225, s[36:39], s6 offen offset:2048 sc1
    buffer_load_dwordx4 v[40:43], v225, s[36:39], s7 offen offset:0 sc1
    s_waitcnt vmcnt(4)
    s_branch L_hchk2
L_hre3:
    s_cmp_eq_u32 s96, 0
    s_cbranch_scc1 L_hok3
    s_sub_u32 s96, s96, 1
    s_cmp_gt_u32 s96, 131040
    s_cbranch_scc1 L_hnr3
    buffer_store_dwordx4 v[240:243], v233, s[36:39], s62 offen sc1
L_hnr3:
    buffer_load_dwordx4 v[28:31], v225, s[36:39], s89 offen offset:2048 sc1
    buffer_load_dwordx4 v[32:35], v225, s[36:39], s6 offen offset:0 sc1
    buffer_load_dwordx4 v[36:39], v225, s[36:39], s6 offen offset:2048 sc1
    buffer_load_dwordx4 v[40:43], v225, s[36:39], s7 offen offset:0 sc1
    s_waitcnt vmcnt(3)
    s_branch L_hchk3
L_hre4:
    s_cmp_eq_u32 s96, 0
    s_cbranch_scc1 L_hok4
    s_sub_u32 s96, s96, 1
    s_cmp_gt_u32 s96, 131040
    s_cbranch_scc1 L_hnr4
    buffer_store_dwordx4 v[240:243], v233, s[36:39], s62 offen sc1
L_hnr4:
    buffer_load_dwordx4 v[32:35], v225, s[36:39], s6 offen offset:0 sc1
    buffer_load_dwordx4 v[36:39], v225, s[36:39], s6 offen offset:2048 sc1
    buffer_load_dwordx4 v[40:43], v225, s[36:39], s7 offen offset:0 sc1
    s_waitcnt vmcnt(2)
    s_branch L_hchk4
L_hre5:
    s_cmp_eq_u32 s96, 0
    s_cbranch_scc1 L_hok5
    s_sub_u32 s96, s96, 1
    s_cmp_gt_u32 s96, 131040
    s_cbranch_scc1 L_hnr5
    buffer_store_dwordx4 v[240:243], v233, s[36:39], s62 offen sc1
L_hnr5:
    buffer_load_dwordx4 v[36:39], v225, s[36:39], s6 offen offset:2048 sc1
    buffer_load_dwordx4 v[40:43], v225, s[36:39], s7 offen offset:0 sc1
    s_waitcnt vmcnt(1)
    s_branch L_hchk5
L_hre6:
    s_cmp_eq_u32 s96, 0
    s_cbranch_scc1 L_hok6
    s_sub_u32 s96, s96, 1
    s_cmp_gt_u32 s96, 131040
    s_cbranch_scc1 L_hnr6
    buffer_store_dwordx4 v[240:243], v233, s[36:39], s62 offen sc1
L_hnr6:
    buffer_load_dwordx4 v[40:43], v225, s[36:39], s7 offen offset:0 sc1
    s_waitcnt vmcnt(0)
    s_branch L_hchk6
L_xre:
    s_cmp_eq_u32 s97, 0
    s_cbranch_scc1 L_xok
    s_sub_u32 s97, s97, 1
    s_and_b32 s99, s97, 63
    s_cbranch_scc1 L_xld
    buffer_store_dwordx4 v[240:243], v233, s[36:39], s62 offen sc1
    s_branch L_xld
L_xw:
    s_waitcnt vmcnt(0)
    v_cmp_ne_u32 vcc, 0, v3
    s_cbranch_vccz L_fin
    buffer_store_dwordx4 v[240:243], v233, s[36:39], s62 offen sc1
    s_branch L_fin
L_xr:
    buffer_store_dwordx4 v[240:243], v233, s[36:39], s62 offen sc1
    v_mov_b32 v3, 0
    s_branch L_xr1
L_rre:
    s_cmp_eq_u32 s96, 0
    s_cbranch_scc1 L_rok
    s_sub_u32 s96, s96, 1
    s_branch L_rld
L_epi:
L_end:
    s_endpgm
.section .rodata,"a"
.p2align 6
.amdhsa_kernel standalone__glu_gated_geglu__sampling_kernel
  .amdhsa_next_free_vgpr 248
  .amdhsa_next_free_sgpr 100
  .amdhsa_accum_offset 248
  .amdhsa_group_segment_fixed_size 0
  .amdhsa_kernarg_size 56
  .amdhsa_user_sgpr_count 2
  .amdhsa_user_sgpr_kernarg_segment_ptr 1
  .amdhsa_system_sgpr_workgroup_id_x 1
  .amdhsa_float_denorm_mode_32 3
.end_amdhsa_kernel
```
